```python
import torch

def _softmax(x, axis=-1):
    return torch.softmax(x, dim=axis)
def _gelu(x):
    return torch.nn.functional.gelu(x, approximate="tanh")
def _silu(x):
    return torch.nn.functional.silu(x)
def _sigmoid(x):
    return torch.sigmoid(x)
def _layernorm(x, axis=-1, eps=1e-5):
    m = x.mean(dim=axis, keepdim=True)
    v = x.var(dim=axis, keepdim=True, unbiased=False)
    return (x - m) / torch.sqrt(v + eps)
def _scatter_add(tgt, idx, src, axis=0):
    return tgt.clone().index_add_(axis, idx, src)
def _segment_sum(src, seg, n):
    out = torch.zeros((n,) + src.shape[1:], dtype=src.dtype)
    return out.index_add_(0, seg, src)
def _pad(x, pw):
    flat = tuple(v for pair in reversed(pw) for v in pair)
    return torch.nn.functional.pad(x, flat)

kernel_name = 'gated_mix__sliding_block_cached__sliding_block_cached__decode'

def setup_inputs():

    _w = (lambda a: (lambda t: t.to(torch.bfloat16) if t.is_floating_point() else t)(torch.as_tensor(a)))
    def _A_setup():
        B, Sq, D = 1, 1, 512
        Hq, Hkv, Sk, Dh = 32, 8, 65536, 128
        assert Hq % Hkv == 0, (Hq, Hkv)
        return {
            "x": _w((lambda *s: torch.randn(*s, dtype=torch.bfloat16) * 0.05)(B, Sq, D)),
            "k_cache": _w((lambda *s: torch.randn(*s, dtype=torch.bfloat16) * 6.4)(B, Hkv, Sk, Dh)),
            "v_cache": _w((lambda *s: torch.randn(*s, dtype=torch.bfloat16) * 0.05)(B, Hkv, Sk, Dh)),
            "wq": _w((lambda *s: torch.randn(*s, dtype=torch.bfloat16) * 6.4)(D, Hq * Dh) * (D ** -0.5)),
            "wo": _w((lambda *s: torch.randn(*s, dtype=torch.bfloat16) * 0.05)(Hq * Dh, D) * ((Hq * Dh) ** -0.5)),
        }
    _A_in = _A_setup()

    def _B_setup():
        B, Sq, D = 1, 1, 512
        Hq, Hkv, Sk, Dh = 32, 8, 65536, 128
        assert Hq % Hkv == 0, (Hq, Hkv)
        return {
            "x": _w((lambda *s: torch.randn(*s, dtype=torch.bfloat16) * 0.05)(B, Sq, D)),
            "k_cache": _w((lambda *s: torch.randn(*s, dtype=torch.bfloat16) * 6.4)(B, Hkv, Sk, Dh)),
            "v_cache": _w((lambda *s: torch.randn(*s, dtype=torch.bfloat16) * 0.05)(B, Hkv, Sk, Dh)),
            "wq": _w((lambda *s: torch.randn(*s, dtype=torch.bfloat16) * 6.4)(D, Hq * Dh) * (D ** -0.5)),
            "wo": _w((lambda *s: torch.randn(*s, dtype=torch.bfloat16) * 0.05)(Hq * Dh, D) * ((Hq * Dh) ** -0.5)),
        }
    _B_in = _B_setup()

    return {
        "A_x": _A_in["x"],
        "A_k_cache": _A_in["k_cache"],
        "A_v_cache": _A_in["v_cache"],
        "A_wq": _A_in["wq"],
        "A_wo": _A_in["wo"],
        "B_x": _B_in["x"],
        "B_k_cache": _B_in["k_cache"],
        "B_v_cache": _B_in["v_cache"],
        "B_wq": _B_in["wq"],
        "B_wo": _B_in["wo"],
        "gate_w": _w((lambda *s: torch.randn(*s, dtype=torch.bfloat16) * 0.05)(512) * 16.0),
    }

def reference(A_x, A_k_cache, A_v_cache, A_wq, A_wo, B_x, B_k_cache, B_v_cache, B_wq, B_wo, gate_w):
    def _A_ref(x, k_cache, v_cache, wq, wo):
        B, Sq, D = x.shape
        Hq, Dh = 32, 128
        Hkv, Sk = k_cache.shape[1], k_cache.shape[2]
        W = min(4096, max(256, Sk // 4))
        rep = Hq // Hkv
        q = (lambda x, *d: x.permute(*d))((x @ wq).reshape(B, Sq, Hq, Dh), 0, 2, 1, 3)
        k = (lambda x, n, axis: torch.repeat_interleave(x, n, dim=axis))(k_cache[:, :, Sk - W:, :], rep, axis=1)
        v = (lambda x, n, axis: torch.repeat_interleave(x, n, dim=axis))(v_cache[:, :, Sk - W:, :], rep, axis=1)
        scores = torch.einsum("bhqd,bhkd->bhqk", q, k) * (Dh ** -0.5)
        p = _softmax(scores, axis=-1)
        o = torch.einsum("bhqk,bhkd->bhqd", p, v)
        return (lambda x, *d: x.permute(*d))(o, 0, 2, 1, 3).reshape(B, Sq, Hq * Dh) @ wo

    def _B_ref(x, k_cache, v_cache, wq, wo):
        B, Sq, D = x.shape
        Hq, Dh = 32, 128
        Hkv, Sk = k_cache.shape[1], k_cache.shape[2]
        W = min(4096, max(256, Sk // 4))
        rep = Hq // Hkv
        q = (lambda x, *d: x.permute(*d))((x @ wq).reshape(B, Sq, Hq, Dh), 0, 2, 1, 3)
        k = (lambda x, n, axis: torch.repeat_interleave(x, n, dim=axis))(k_cache[:, :, Sk - W:, :], rep, axis=1)
        v = (lambda x, n, axis: torch.repeat_interleave(x, n, dim=axis))(v_cache[:, :, Sk - W:, :], rep, axis=1)
        scores = torch.einsum("bhqd,bhkd->bhqk", q, k) * (Dh ** -0.5)
        p = _softmax(scores, axis=-1)
        o = torch.einsum("bhqk,bhkd->bhqd", p, v)
        return (lambda x, *d: x.permute(*d))(o, 0, 2, 1, 3).reshape(B, Sq, Hq * Dh) @ wo

    x = A_x
    g = _sigmoid((x * gate_w).sum(-1, keepdims=True))
    a = _A_ref(x, A_k_cache, A_v_cache, A_wq, A_wo)
    b = _B_ref(x, B_k_cache, B_v_cache, B_wq, B_wo)
    return g * a + (1 - g) * b
```

```asm
; @launch grid=(256,1,1) block=(320,1,1) lds=90112
.amdgcn_target "amdgcn-amd-amdhsa--gfx950"
.text
.globl gated_mix__sliding_block_cached__sliding_block_cached__decode_kernel
.p2align 8
.type gated_mix__sliding_block_cached__sliding_block_cached__decode_kernel,@function
gated_mix__sliding_block_cached__sliding_block_cached__decode_kernel:
    s_and_b32 s29, s2, 8
    s_mul_i32 s29, s29, 5
    s_load_dwordx8 s[8:15], s[0:1], s29 offset:0x8
    s_load_dwordx2 s[4:5], s[0:1], 0
    v_readfirstlane_b32 s27, v0
    s_cmpk_ge_u32 s2, 0x100
    s_cbranch_scc1 L_end
    v_and_b32 v4, 15, v0
    s_and_b32 s24, s2, 7
    s_cmpk_lt_u32 s27, 0x100
    s_cbranch_scc1 L_comp
    s_getpc_b64 s[6:7]
L_pc:
    v_lshlrev_b32 v5, 7, v0
    v_min_u32 v5, L_end-L_pc+0x8000, v5
    s_sub_u32 s6, s6, 0x8000
    s_subb_u32 s7, s7, 0
    global_load_dword v6, v5, s[6:7]
    s_branch L_comm
L_comp:
    s_lshr_b32 s30, s2, 6
    s_lshl2_add_u32 s29, s24, s30
    s_and_b32 s30, s2, 48
    v_lshrrev_b32 v6, 4, v0
    v_lshl_or_b32 v5, s29, 4, v4
    v_add_u32 v6, s30, v6
    s_movk_i32 s30, 0x2000
    v_lshlrev_b32 v9, 4, v6
    v_lshl_or_b32 v5, v6, 12, v5
    v_lshlrev_b32 v40, 4, v5
    v_add_u32 v41, s30, v40
    v_add_u32 v42, s30, v41
    v_add_u32 v43, s30, v42
    v_add_u32 v44, s30, v43
    v_add_u32 v45, s30, v44
    v_add_u32 v46, s30, v45
    v_add_u32 v47, s30, v46
    s_waitcnt lgkmcnt(0)
    global_load_dwordx4 v[24:27], v9, s[4:5]
    global_load_dwordx4 v[72:75], v40, s[12:13] nt
    global_load_dwordx4 v[76:79], v41, s[12:13] nt
    global_load_dwordx4 v[80:83], v42, s[12:13] nt
    global_load_dwordx4 v[84:87], v43, s[12:13] nt
    global_load_dwordx4 v[88:91], v44, s[12:13] nt
    global_load_dwordx4 v[92:95], v45, s[12:13] nt
    global_load_dwordx4 v[96:99], v46, s[12:13] nt
    global_load_dwordx4 v[100:103], v47, s[12:13] nt
L_first:
    s_load_dwordx8 s[16:23], s[0:1], 80
    v_lshrrev_b32 v2, 6, v0
    v_and_b32 v1, 63, v0
    v_bfe_u32 v3, v0, 4, 2
    s_lshr_b32 s27, s27, 6
    s_bfe_u32 s25, s2, 0x10003
    s_lshr_b32 s26, s2, 4
    s_lshl1_add_u32 s28, s24, s25
    s_lshl_b32 s29, s29, 8
    s_lshl_b32 s30, s24, 24
    s_lshl_b32 s31, s26, 12
    s_add_u32 s30, s30, s31
    s_add_u32 s30, s30, 0xF00000
    v_bfe_u32 v6, v1, 2, 2
    v_lshlrev_b32 v6, 8, v6
    v_lshl_add_u32 v6, v3, 6, v6
    v_and_b32 v5, 3, v1
    v_lshl_add_u32 v6, v5, 4, v6
    v_lshl_add_u32 v6, v2, 10, v6
    v_add_u32 v6, s30, v6
    v_lshlrev_b32 v7, 4, v0
    v_add_u32 v7, s30, v7
    s_lshl_b32 s29, s29, 9
    s_and_b32 s30, s26, 3
    s_lshl_b32 s30, s30, 8
    s_add_u32 s29, s29, s30
    v_and_b32 v5, 1, v3
    v_lshlrev_b32 v8, 11, v5
    v_lshrrev_b32 v5, 1, v3
    v_lshl_add_u32 v8, v5, 10, v8
    v_lshl_add_u32 v8, v2, 15, v8
    v_lshl_add_u32 v8, v4, 4, v8
    v_add_u32 v8, s29, v8
    v_and_b32 v5, 1, v1
    v_lshlrev_b32 v5, 4, v5
    s_mov_b32 s29, 0xffff
    v_lshlrev_b32 v5, v5, s29
    v_bfe_u32 v48, v1, 1, 2
    v_cmp_eq_u32 vcc, 0, v48
    s_nop 1
    v_cndmask_b32 v10, 0, v5, vcc
    v_cmp_eq_u32 vcc, 1, v48
    s_nop 1
    v_cndmask_b32 v11, 0, v5, vcc
    v_cmp_eq_u32 vcc, 2, v48
    s_nop 1
    v_cndmask_b32 v12, 0, v5, vcc
    v_cmp_eq_u32 vcc, 3, v48
    s_nop 1
    v_cndmask_b32 v13, 0, v5, vcc
    v_or_b32 v14, v10, v12
    v_or_b32 v15, v11, v13
    s_mov_b32 s36, 0x3db504f3
    s_mov_b32 s37, 0x3db504f3
    s_mov_b32 s38, 0x3fb8aa3b
    s_mov_b32 s39, 0x3fb8aa3b
    s_mov_b32 s34, 0xffff0000
    s_mov_b32 s29, 0x01000100
    s_mov_b32 s30, 0x03020302
    v_mov_b32 v18, 0
    v_mov_b32 v19, 1
    s_waitcnt vmcnt(8)
    v_perm_b32 v48, v24, v24, s29
    v_perm_b32 v49, v24, v24, s30
    v_perm_b32 v50, v25, v25, s29
    v_perm_b32 v51, v25, v25, s30
    v_perm_b32 v52, v26, v26, s29
    v_perm_b32 v53, v26, v26, s30
    v_perm_b32 v54, v27, v27, s29
    v_perm_b32 v55, v27, v27, s30
    v_and_b32 v104, v48, v10
    v_and_b32 v105, v48, v11
    v_and_b32 v106, v48, v12
    v_and_b32 v107, v48, v13
    v_and_b32 v108, v49, v10
    v_and_b32 v109, v49, v11
    v_and_b32 v110, v49, v12
    v_and_b32 v111, v49, v13
    v_and_b32 v112, v50, v10
    v_and_b32 v113, v50, v11
    v_and_b32 v114, v50, v12
    v_and_b32 v115, v50, v13
    v_and_b32 v116, v51, v10
    v_and_b32 v117, v51, v11
    v_and_b32 v118, v51, v12
    v_and_b32 v119, v51, v13
    v_and_b32 v120, v52, v10
    v_and_b32 v121, v52, v11
    v_and_b32 v122, v52, v12
    v_and_b32 v123, v52, v13
    v_and_b32 v124, v53, v10
    v_and_b32 v125, v53, v11
    v_and_b32 v126, v53, v12
    v_and_b32 v127, v53, v13
    v_and_b32 v128, v54, v10
    v_and_b32 v129, v54, v11
    v_and_b32 v130, v54, v12
    v_and_b32 v131, v54, v13
    v_and_b32 v132, v55, v10
    v_and_b32 v133, v55, v11
    v_and_b32 v134, v55, v12
    v_and_b32 v135, v55, v13
    s_waitcnt vmcnt(7)
    v_mfma_f32_16x16x32_bf16 v[32:35], v[104:107], v[72:75], 0
    s_waitcnt vmcnt(6)
    v_mfma_f32_16x16x32_bf16 v[32:35], v[108:111], v[76:79], v[32:35]
    s_waitcnt vmcnt(5)
    v_mfma_f32_16x16x32_bf16 v[32:35], v[112:115], v[80:83], v[32:35]
    global_load_dwordx4 v[136:139], v6, s[8:9] nt
    s_waitcnt vmcnt(5)
    v_mfma_f32_16x16x32_bf16 v[32:35], v[116:119], v[84:87], v[32:35]
    v_xor_b32 v16, 0x11000, v6
    global_load_dwordx4 v[140:143], v16, s[8:9] nt
    s_waitcnt vmcnt(5)
    v_mfma_f32_16x16x32_bf16 v[32:35], v[120:123], v[88:91], v[32:35]
    v_xor_b32 v17, 0x22000, v6
    global_load_dwordx4 v[144:147], v17, s[8:9] nt
    s_waitcnt vmcnt(5)
    v_mfma_f32_16x16x32_bf16 v[32:35], v[124:127], v[92:95], v[32:35]
    v_xor_b32 v16, 0x33000, v6
    global_load_dwordx4 v[148:151], v16, s[8:9] nt
    s_waitcnt vmcnt(5)
    v_mfma_f32_16x16x32_bf16 v[32:35], v[128:131], v[96:99], v[32:35]
    v_xor_b32 v17, 0x44000, v6
    global_load_dwordx4 v[152:155], v17, s[8:9] nt
    s_waitcnt vmcnt(5)
    v_mfma_f32_16x16x32_bf16 v[32:35], v[132:135], v[100:103], v[32:35]
    v_xor_b32 v16, 0x55000, v6
    global_load_dwordx4 v[156:159], v16, s[8:9] nt
    v_and_b32 v96, 1, v3
    v_lshlrev_b32 v96, 4, v96
    v_lshl_add_u32 v96, v4, 5, v96
    v_lshl_add_u32 v96, v2, 9, v96
    s_mov_b32 exec_hi, 0
    s_nop 2
    ds_write_b128 v96, v[32:35] offset:0
    s_mov_b64 exec, -1
    s_waitcnt lgkmcnt(0)
    s_barrier
    s_waitcnt vmcnt(5)
    v_xor_b32 v17, 0x66000, v6
    global_load_dwordx4 v[160:163], v17, s[8:9] nt
    s_waitcnt vmcnt(5)
    v_xor_b32 v16, 0x77000, v6
    global_load_dwordx4 v[164:167], v16, s[8:9] nt
    s_waitcnt vmcnt(5)
    v_xor_b32 v17, 0x88000, v6
    global_load_dwordx4 v[168:171], v17, s[8:9] nt
    v_lshlrev_b32 v20, 11, v2
    v_lshl_add_u32 v20, v1, 4, v20
    v_and_b32 v5, 1, v1
    v_lshlrev_b32 v21, 10, v5
    v_lshl_add_u32 v21, v2, 8, v21
    v_bfe_u32 v5, v1, 1, 4
    v_lshl_add_u32 v21, v5, 4, v21
    s_waitcnt vmcnt(5)
    global_load_dwordx4 v[200:203], v7, s[10:11] nt
    s_lshl_b32 s29, s28, 15
    s_add_u32 s29, s29, 0x80000
    s_lshl_b32 s30, s26, 7
    s_add_u32 s30, s30, s29
    v_bfe_u32 v22, v1, 3, 2
    v_lshl_add_u32 v22, v2, 2, v22
    v_lshlrev_b32 v22, 11, v22
    v_and_b32 v5, 7, v1
    v_lshl_add_u32 v22, v5, 4, v22
    v_add_u32 v22, s30, v22
    s_and_b32 s30, s26, 12
    s_lshl_b32 s30, s30, 11
    s_add_u32 s30, s30, s29
    v_add_u32 v23, s30, v20
    s_mov_b32 s50, 0
    s_mov_b32 s51, -1
    s_lshl_b32 s29, s28, 10
    s_add_u32 s29, s29, 0x10000
    s_lshl_b32 s30, s26, 4
    s_add_u32 s30, s30, s29
    v_lshlrev_b32 v5, 8, v2
    v_add_u32 v5, s30, v5
    v_cndmask_b32 v22, v22, v5, s[50:51]
    s_lshr_b32 s30, s26, 2
    s_lshl_b32 s30, s30, 8
    s_add_u32 s30, s30, s29
    v_lshrrev_b32 v97, 3, v1
    v_and_b32 v5, 1, v1
    v_lshl_add_u32 v97, v5, 3, v97
    v_lshlrev_b32 v97, 4, v97
    v_add_u32 v97, s30, v97
    v_lshlrev_b32 v98, 4, v2
    s_waitcnt vmcnt(5)
    v_xor_b32 v16, 0x99000, v6
    global_load_dwordx4 v[172:175], v16, s[8:9] nt
    s_waitcnt vmcnt(5)
    v_xor_b32 v17, 0x11000, v7
    global_load_dwordx4 v[204:207], v17, s[10:11] nt
    s_waitcnt vmcnt(5)
    v_xor_b32 v16, 0xaa000, v6
    global_load_dwordx4 v[176:179], v16, s[8:9] nt
    s_waitcnt vmcnt(5)
    v_xor_b32 v17, 0x22000, v7
    global_load_dwordx4 v[208:211], v17, s[10:11] nt
    s_waitcnt vmcnt(5)
    v_xor_b32 v16, 0xbb000, v6
    global_load_dwordx4 v[180:183], v16, s[8:9] nt
    s_waitcnt vmcnt(5)
    v_xor_b32 v17, 0x33000, v7
    global_load_dwordx4 v[212:215], v17, s[10:11] nt
    s_waitcnt vmcnt(5)
    v_xor_b32 v16, 0xcc000, v6
    global_load_dwordx4 v[184:187], v16, s[8:9] nt
    s_waitcnt vmcnt(5)
    v_xor_b32 v17, 0x44000, v7
    global_load_dwordx4 v[216:219], v17, s[10:11] nt
    s_waitcnt vmcnt(5)
    v_xor_b32 v16, 0xdd000, v6
    global_load_dwordx4 v[188:191], v16, s[8:9] nt
    s_waitcnt vmcnt(5)
    v_xor_b32 v17, 0x55000, v7
    global_load_dwordx4 v[220:223], v17, s[10:11] nt
    s_waitcnt vmcnt(5)
    v_xor_b32 v16, 0xee000, v6
    global_load_dwordx4 v[192:195], v16, s[8:9] nt
    s_waitcnt vmcnt(5)
    v_xor_b32 v17, 0x66000, v7
    global_load_dwordx4 v[224:227], v17, s[10:11] nt
    v_xor_b32 v16, 0xff000, v6
    global_load_dwordx4 v[196:199], v16, s[8:9] nt
    v_xor_b32 v17, 0x77000, v7
    global_load_dwordx4 v[228:231], v17, s[10:11] nt
    v_xor_b32 v16, 0x88000, v7
    global_load_dwordx4 v[232:235], v16, s[10:11] nt
    v_xor_b32 v17, 0x99000, v7
    global_load_dwordx4 v[236:239], v17, s[10:11] nt
    v_xor_b32 v16, 0xaa000, v7
    global_load_dwordx4 v[240:243], v16, s[10:11] nt
    s_barrier
    v_lshlrev_b32 v5, 4, v1
    ds_read_b128 v[28:31], v5 offset:2048
    ds_read_b64 v[40:41], v18 offset:3144
    s_waitcnt lgkmcnt(0)
    v_readfirstlane_b32 s40, v40
    v_readfirstlane_b32 s32, v41
    v_lshrrev_b32 v53, 2, v4
    v_lshlrev_b32 v53, 4, v53
    v_lshl_add_u32 v52, v2, 2, v53
    v_mfma_f32_16x16x32_bf16 v[80:83], v[136:139], v[28:31], 0
    v_mfma_f32_16x16x32_bf16 v[84:87], v[140:143], v[28:31], 0
    v_mfma_f32_16x16x32_bf16 v[88:91], v[144:147], v[28:31], 0
    v_mfma_f32_16x16x32_bf16 v[92:95], v[148:151], v[28:31], 0
    s_nop 4
    v_mov_b32_dpp v56, v80 quad_perm:[0,0,0,0] row_mask:0xf bank_mask:0xf
    v_mov_b32_dpp v57, v84 quad_perm:[0,0,0,0] row_mask:0xf bank_mask:0xf
    v_mov_b32_dpp v58, v88 quad_perm:[0,0,0,0] row_mask:0xf bank_mask:0xf
    v_mov_b32_dpp v59, v92 quad_perm:[0,0,0,0] row_mask:0xf bank_mask:0xf
    v_add_f32_dpp v56, v81, v56 quad_perm:[1,1,1,1] row_mask:0xf bank_mask:0xf
    v_add_f32_dpp v57, v85, v57 quad_perm:[1,1,1,1] row_mask:0xf bank_mask:0xf
    v_add_f32_dpp v58, v89, v58 quad_perm:[1,1,1,1] row_mask:0xf bank_mask:0xf
    v_add_f32_dpp v59, v93, v59 quad_perm:[1,1,1,1] row_mask:0xf bank_mask:0xf
    v_add_f32_dpp v56, v82, v56 quad_perm:[2,2,2,2] row_mask:0xf bank_mask:0xf
    v_add_f32_dpp v57, v86, v57 quad_perm:[2,2,2,2] row_mask:0xf bank_mask:0xf
    v_add_f32_dpp v58, v90, v58 quad_perm:[2,2,2,2] row_mask:0xf bank_mask:0xf
    v_add_f32_dpp v59, v94, v59 quad_perm:[2,2,2,2] row_mask:0xf bank_mask:0xf
    v_add_f32_dpp v56, v83, v56 quad_perm:[3,3,3,3] row_mask:0xf bank_mask:0xf
    v_add_f32_dpp v57, v87, v57 quad_perm:[3,3,3,3] row_mask:0xf bank_mask:0xf
    v_add_f32_dpp v58, v91, v58 quad_perm:[3,3,3,3] row_mask:0xf bank_mask:0xf
    v_add_f32_dpp v59, v95, v59 quad_perm:[3,3,3,3] row_mask:0xf bank_mask:0xf
    v_cvt_pk_bf16_f32 v40, v56, v57
    v_cvt_pk_bf16_f32 v41, v58, v59
    v_lshlrev_b32 v56, 16, v40
    v_and_b32 v57, s34, v40
    v_lshlrev_b32 v58, 16, v41
    v_and_b32 v59, s34, v41
    v_pk_mul_f32 v[56:57], v[56:57], s[36:37]
    v_pk_mul_f32 v[58:59], v[58:59], s[36:37]
    v_cvt_pk_bf16_f32 v40, v56, v57
    v_cvt_pk_bf16_f32 v41, v58, v59
    v_lshlrev_b32 v56, 16, v40
    v_and_b32 v57, s34, v40
    v_lshlrev_b32 v58, 16, v41
    v_and_b32 v59, s34, v41
    v_max3_f32 v48, v56, v57, v58
    v_max_f32 v48, v48, v59
    v_mfma_f32_16x16x32_bf16 v[80:83], v[152:155], v[28:31], 0
    v_mfma_f32_16x16x32_bf16 v[84:87], v[156:159], v[28:31], 0
    v_mfma_f32_16x16x32_bf16 v[88:91], v[160:163], v[28:31], 0
    v_mfma_f32_16x16x32_bf16 v[92:95], v[164:167], v[28:31], 0
    s_nop 4
    v_mov_b32_dpp v60, v80 quad_perm:[0,0,0,0] row_mask:0xf bank_mask:0xf
    v_mov_b32_dpp v61, v84 quad_perm:[0,0,0,0] row_mask:0xf bank_mask:0xf
    v_mov_b32_dpp v62, v88 quad_perm:[0,0,0,0] row_mask:0xf bank_mask:0xf
    v_mov_b32_dpp v63, v92 quad_perm:[0,0,0,0] row_mask:0xf bank_mask:0xf
    v_add_f32_dpp v60, v81, v60 quad_perm:[1,1,1,1] row_mask:0xf bank_mask:0xf
    v_add_f32_dpp v61, v85, v61 quad_perm:[1,1,1,1] row_mask:0xf bank_mask:0xf
    v_add_f32_dpp v62, v89, v62 quad_perm:[1,1,1,1] row_mask:0xf bank_mask:0xf
    v_add_f32_dpp v63, v93, v63 quad_perm:[1,1,1,1] row_mask:0xf bank_mask:0xf
    v_add_f32_dpp v60, v82, v60 quad_perm:[2,2,2,2] row_mask:0xf bank_mask:0xf
    v_add_f32_dpp v61, v86, v61 quad_perm:[2,2,2,2] row_mask:0xf bank_mask:0xf
    v_add_f32_dpp v62, v90, v62 quad_perm:[2,2,2,2] row_mask:0xf bank_mask:0xf
    v_add_f32_dpp v63, v94, v63 quad_perm:[2,2,2,2] row_mask:0xf bank_mask:0xf
    v_add_f32_dpp v60, v83, v60 quad_perm:[3,3,3,3] row_mask:0xf bank_mask:0xf
    v_add_f32_dpp v61, v87, v61 quad_perm:[3,3,3,3] row_mask:0xf bank_mask:0xf
    v_add_f32_dpp v62, v91, v62 quad_perm:[3,3,3,3] row_mask:0xf bank_mask:0xf
    v_add_f32_dpp v63, v95, v63 quad_perm:[3,3,3,3] row_mask:0xf bank_mask:0xf
    v_cvt_pk_bf16_f32 v40, v60, v61
    v_cvt_pk_bf16_f32 v41, v62, v63
    v_lshlrev_b32 v60, 16, v40
    v_and_b32 v61, s34, v40
    v_lshlrev_b32 v62, 16, v41
    v_and_b32 v63, s34, v41
    v_pk_mul_f32 v[60:61], v[60:61], s[36:37]
    v_pk_mul_f32 v[62:63], v[62:63], s[36:37]
    v_cvt_pk_bf16_f32 v40, v60, v61
    v_cvt_pk_bf16_f32 v41, v62, v63
    v_lshlrev_b32 v60, 16, v40
    v_and_b32 v61, s34, v40
    v_lshlrev_b32 v62, 16, v41
    v_and_b32 v63, s34, v41
    s_bfe_u32 s29, s32, 0xa0000
    v_mov_b32 v24, s29
    s_bfe_u32 s29, s32, 0xa000a
    v_mov_b32 v25, s29
    s_bfe_u32 s29, s32, 0xa0014
    v_mov_b32 v26, s29
    s_bfe_u32 s29, s32, 0xa0016
    v_mov_b32 v27, s29
    s_mov_b32 s33, 0xfffffc00
    v_max3_f32 v48, v48, v60, v61
    v_max3_f32 v48, v48, v62, v63
    v_mfma_f32_16x16x32_bf16 v[80:83], v[168:171], v[28:31], 0
    v_mfma_f32_16x16x32_bf16 v[84:87], v[172:175], v[28:31], 0
    v_mfma_f32_16x16x32_bf16 v[88:91], v[176:179], v[28:31], 0
    v_mfma_f32_16x16x32_bf16 v[92:95], v[180:183], v[28:31], 0
    s_nop 4
    v_mov_b32_dpp v64, v80 quad_perm:[0,0,0,0] row_mask:0xf bank_mask:0xf
    v_mov_b32_dpp v65, v84 quad_perm:[0,0,0,0] row_mask:0xf bank_mask:0xf
    v_mov_b32_dpp v66, v88 quad_perm:[0,0,0,0] row_mask:0xf bank_mask:0xf
    v_mov_b32_dpp v67, v92 quad_perm:[0,0,0,0] row_mask:0xf bank_mask:0xf
    v_add_f32_dpp v64, v81, v64 quad_perm:[1,1,1,1] row_mask:0xf bank_mask:0xf
    v_add_f32_dpp v65, v85, v65 quad_perm:[1,1,1,1] row_mask:0xf bank_mask:0xf
    v_add_f32_dpp v66, v89, v66 quad_perm:[1,1,1,1] row_mask:0xf bank_mask:0xf
    v_add_f32_dpp v67, v93, v67 quad_perm:[1,1,1,1] row_mask:0xf bank_mask:0xf
    v_add_f32_dpp v64, v82, v64 quad_perm:[2,2,2,2] row_mask:0xf bank_mask:0xf
    v_add_f32_dpp v65, v86, v65 quad_perm:[2,2,2,2] row_mask:0xf bank_mask:0xf
    v_add_f32_dpp v66, v90, v66 quad_perm:[2,2,2,2] row_mask:0xf bank_mask:0xf
    v_add_f32_dpp v67, v94, v67 quad_perm:[2,2,2,2] row_mask:0xf bank_mask:0xf
    v_add_f32_dpp v64, v83, v64 quad_perm:[3,3,3,3] row_mask:0xf bank_mask:0xf
    v_add_f32_dpp v65, v87, v65 quad_perm:[3,3,3,3] row_mask:0xf bank_mask:0xf
    v_add_f32_dpp v66, v91, v66 quad_perm:[3,3,3,3] row_mask:0xf bank_mask:0xf
    v_add_f32_dpp v67, v95, v67 quad_perm:[3,3,3,3] row_mask:0xf bank_mask:0xf
    v_cvt_pk_bf16_f32 v40, v64, v65
    v_cvt_pk_bf16_f32 v41, v66, v67
    v_lshlrev_b32 v64, 16, v40
    v_and_b32 v65, s34, v40
    v_lshlrev_b32 v66, 16, v41
    v_and_b32 v67, s34, v41
    v_pk_mul_f32 v[64:65], v[64:65], s[36:37]
    v_pk_mul_f32 v[66:67], v[66:67], s[36:37]
    v_cvt_pk_bf16_f32 v40, v64, v65
    v_cvt_pk_bf16_f32 v41, v66, v67
    v_lshlrev_b32 v64, 16, v40
    v_and_b32 v65, s34, v40
    v_lshlrev_b32 v66, 16, v41
    v_and_b32 v67, s34, v41
    v_max3_f32 v48, v48, v64, v65
    v_max3_f32 v48, v48, v66, v67
    s_waitcnt vmcnt(10)
    v_mfma_f32_16x16x32_bf16 v[80:83], v[184:187], v[28:31], 0
    s_waitcnt vmcnt(9)
    v_xor_b32 v17, 0xbb000, v7
    global_load_dwordx4 v[244:247], v17, s[10:11] nt
    s_waitcnt vmcnt(9)
    v_mfma_f32_16x16x32_bf16 v[84:87], v[188:191], v[28:31], 0
    v_xor_b32 v16, 0xcc000, v7
    global_load_dwordx4 v[248:251], v16, s[10:11] nt
    s_waitcnt vmcnt(9)
    v_xor_b32 v17, 0xdd000, v7
    global_load_dwordx4 v[252:255], v17, s[10:11] nt
    s_waitcnt vmcnt(9)
    v_mfma_f32_16x16x32_bf16 v[88:91], v[192:195], v[28:31], 0
    v_xor_b32 v16, 0xee000, v7
    global_load_dwordx4 v[72:75], v16, s[10:11] nt
    s_waitcnt vmcnt(9)
    v_xor_b32 v17, 0xff000, v7
    global_load_dwordx4 v[76:79], v17, s[10:11] nt
    s_waitcnt vmcnt(9)
    v_mfma_f32_16x16x32_bf16 v[92:95], v[196:199], v[28:31], 0
    global_load_dwordx4 v[104:107], v8, s[14:15] nt
    s_nop 3
    v_mov_b32_dpp v68, v80 quad_perm:[0,0,0,0] row_mask:0xf bank_mask:0xf
    v_mov_b32_dpp v69, v84 quad_perm:[0,0,0,0] row_mask:0xf bank_mask:0xf
    v_mov_b32_dpp v70, v88 quad_perm:[0,0,0,0] row_mask:0xf bank_mask:0xf
    v_mov_b32_dpp v71, v92 quad_perm:[0,0,0,0] row_mask:0xf bank_mask:0xf
    v_add_f32_dpp v68, v81, v68 quad_perm:[1,1,1,1] row_mask:0xf bank_mask:0xf
    v_add_f32_dpp v69, v85, v69 quad_perm:[1,1,1,1] row_mask:0xf bank_mask:0xf
    v_add_f32_dpp v70, v89, v70 quad_perm:[1,1,1,1] row_mask:0xf bank_mask:0xf
    v_add_f32_dpp v71, v93, v71 quad_perm:[1,1,1,1] row_mask:0xf bank_mask:0xf
    v_add_f32_dpp v68, v82, v68 quad_perm:[2,2,2,2] row_mask:0xf bank_mask:0xf
    v_add_f32_dpp v69, v86, v69 quad_perm:[2,2,2,2] row_mask:0xf bank_mask:0xf
    v_add_f32_dpp v70, v90, v70 quad_perm:[2,2,2,2] row_mask:0xf bank_mask:0xf
    v_add_f32_dpp v71, v94, v71 quad_perm:[2,2,2,2] row_mask:0xf bank_mask:0xf
    v_add_f32_dpp v68, v83, v68 quad_perm:[3,3,3,3] row_mask:0xf bank_mask:0xf
    v_add_f32_dpp v69, v87, v69 quad_perm:[3,3,3,3] row_mask:0xf bank_mask:0xf
    v_add_f32_dpp v70, v91, v70 quad_perm:[3,3,3,3] row_mask:0xf bank_mask:0xf
    v_add_f32_dpp v71, v95, v71 quad_perm:[3,3,3,3] row_mask:0xf bank_mask:0xf
    v_cvt_pk_bf16_f32 v40, v68, v69
    v_cvt_pk_bf16_f32 v41, v70, v71
    v_lshlrev_b32 v68, 16, v40
    v_and_b32 v69, s34, v40
    v_lshlrev_b32 v70, 16, v41
    v_and_b32 v71, s34, v41
    v_pk_mul_f32 v[68:69], v[68:69], s[36:37]
    v_pk_mul_f32 v[70:71], v[70:71], s[36:37]
    v_cvt_pk_bf16_f32 v40, v68, v69
    v_cvt_pk_bf16_f32 v41, v70, v71
    v_lshlrev_b32 v68, 16, v40
    v_and_b32 v69, s34, v40
    v_lshlrev_b32 v70, 16, v41
    v_and_b32 v71, s34, v41
    v_max3_f32 v48, v48, v68, v69
    v_max3_f32 v48, v48, v70, v71
    v_mov_b32 v50, v48
    s_nop 1
    v_permlane32_swap_b32 v48, v50
    v_max_f32 v48, v48, v50
    v_mov_b32 v50, v48
    s_nop 1
    v_permlane16_swap_b32 v48, v50
    v_max_f32 v48, v48, v50
    ds_write_b32 v52, v48 offset:3072
    s_waitcnt lgkmcnt(0)
    s_barrier
    ds_read_b128 v[40:43], v53 offset:3072
    ds_read_b128 v[44:47], v98 offset:3072
    v_xor_b32 v16, 0x1000, v8
    global_load_dwordx4 v[108:111], v16, s[14:15] nt
    v_xor_b32 v17, 0x2000, v8
    global_load_dwordx4 v[112:115], v17, s[14:15] nt
    s_waitcnt lgkmcnt(0)
    v_max3_f32 v48, v40, v41, v42
    v_max3_f32 v99, v44, v45, v46
    v_max_f32 v48, v48, v43
    v_max_f32 v99, v99, v47
    v_mul_f32 v50, s38, v48
    v_mul_f32 v51, s38, v48
    v_pk_fma_f32 v[56:57], v[56:57], s[38:39], v[50:51] neg_lo:[0,0,1] neg_hi:[0,0,1]
    v_exp_f32 v56, v56
    v_exp_f32 v57, v57
    v_pk_fma_f32 v[58:59], v[58:59], s[38:39], v[50:51] neg_lo:[0,0,1] neg_hi:[0,0,1]
    v_exp_f32 v58, v58
    v_exp_f32 v59, v59
    v_cvt_pk_bf16_f32 v136, v56, v56
    v_cvt_pk_bf16_f32 v138, v57, v57
    v_and_b32 v137, v136, v15
    v_and_b32 v136, v136, v14
    v_and_b32 v139, v138, v15
    v_and_b32 v138, v138, v14
    v_pk_fma_f32 v[60:61], v[60:61], s[38:39], v[50:51] neg_lo:[0,0,1] neg_hi:[0,0,1]
    v_exp_f32 v60, v60
    v_mfma_f32_16x16x16_bf16 v[32:35], v[136:137], v[200:201], 0
    v_exp_f32 v61, v61
    v_cvt_pk_bf16_f32 v140, v58, v58
    v_mfma_f32_16x16x16_bf16 v[36:39], v[136:137], v[202:203], 0
    v_cvt_pk_bf16_f32 v142, v59, v59
    v_and_b32 v141, v140, v15
    v_mfma_f32_16x16x16_bf16 v[32:35], v[138:139], v[204:205], v[32:35]
    v_and_b32 v140, v140, v14
    v_and_b32 v143, v142, v15
    v_mfma_f32_16x16x16_bf16 v[36:39], v[138:139], v[206:207], v[36:39]
    v_and_b32 v142, v142, v14
    v_pk_add_f32 v[40:41], v[56:57], v[58:59]
    v_pk_fma_f32 v[62:63], v[62:63], s[38:39], v[50:51] neg_lo:[0,0,1] neg_hi:[0,0,1]
    v_exp_f32 v62, v62
    v_mfma_f32_16x16x16_bf16 v[32:35], v[140:141], v[208:209], v[32:35]
    v_exp_f32 v63, v63
    v_cvt_pk_bf16_f32 v144, v60, v60
    v_mfma_f32_16x16x16_bf16 v[36:39], v[140:141], v[210:211], v[36:39]
    v_cvt_pk_bf16_f32 v146, v61, v61
    v_and_b32 v145, v144, v15
    v_mfma_f32_16x16x16_bf16 v[32:35], v[142:143], v[212:213], v[32:35]
    v_and_b32 v144, v144, v14
    v_and_b32 v147, v146, v15
    v_mfma_f32_16x16x16_bf16 v[36:39], v[142:143], v[214:215], v[36:39]
    v_and_b32 v146, v146, v14
    v_pk_add_f32 v[40:41], v[40:41], v[60:61]
    v_pk_fma_f32 v[64:65], v[64:65], s[38:39], v[50:51] neg_lo:[0,0,1] neg_hi:[0,0,1]
    v_exp_f32 v64, v64
    v_mfma_f32_16x16x16_bf16 v[32:35], v[144:145], v[216:217], v[32:35]
    v_exp_f32 v65, v65
    v_cvt_pk_bf16_f32 v148, v62, v62
    v_mfma_f32_16x16x16_bf16 v[36:39], v[144:145], v[218:219], v[36:39]
    v_cvt_pk_bf16_f32 v150, v63, v63
    v_and_b32 v149, v148, v15
    v_mfma_f32_16x16x16_bf16 v[32:35], v[146:147], v[220:221], v[32:35]
    v_and_b32 v148, v148, v14
    v_and_b32 v151, v150, v15
    v_mfma_f32_16x16x16_bf16 v[36:39], v[146:147], v[222:223], v[36:39]
    v_and_b32 v150, v150, v14
    v_pk_add_f32 v[40:41], v[40:41], v[62:63]
    v_pk_fma_f32 v[66:67], v[66:67], s[38:39], v[50:51] neg_lo:[0,0,1] neg_hi:[0,0,1]
    v_exp_f32 v66, v66
    v_mfma_f32_16x16x16_bf16 v[32:35], v[148:149], v[224:225], v[32:35]
    v_exp_f32 v67, v67
    v_cvt_pk_bf16_f32 v152, v64, v64
    v_mfma_f32_16x16x16_bf16 v[36:39], v[148:149], v[226:227], v[36:39]
    v_cvt_pk_bf16_f32 v154, v65, v65
    v_and_b32 v153, v152, v15
    s_waitcnt vmcnt(11)
    v_mfma_f32_16x16x16_bf16 v[32:35], v[150:151], v[228:229], v[32:35]
    v_and_b32 v152, v152, v14
    v_and_b32 v155, v154, v15
    v_mfma_f32_16x16x16_bf16 v[36:39], v[150:151], v[230:231], v[36:39]
    v_and_b32 v154, v154, v14
    v_pk_add_f32 v[40:41], v[40:41], v[64:65]
    v_pk_fma_f32 v[68:69], v[68:69], s[38:39], v[50:51] neg_lo:[0,0,1] neg_hi:[0,0,1]
    v_exp_f32 v68, v68
    s_waitcnt vmcnt(10)
    v_mfma_f32_16x16x16_bf16 v[32:35], v[152:153], v[232:233], v[32:35]
    v_exp_f32 v69, v69
    v_cvt_pk_bf16_f32 v156, v66, v66
    v_mfma_f32_16x16x16_bf16 v[36:39], v[152:153], v[234:235], v[36:39]
    v_cvt_pk_bf16_f32 v158, v67, v67
    v_and_b32 v157, v156, v15
    s_waitcnt vmcnt(9)
    v_mfma_f32_16x16x16_bf16 v[32:35], v[154:155], v[236:237], v[32:35]
    v_and_b32 v156, v156, v14
    v_and_b32 v159, v158, v15
    v_mfma_f32_16x16x16_bf16 v[36:39], v[154:155], v[238:239], v[36:39]
    v_xor_b32 v16, 0x3000, v8
    global_load_dwordx4 v[116:119], v16, s[14:15] nt
    v_and_b32 v158, v158, v14
    v_pk_add_f32 v[40:41], v[40:41], v[66:67]
    v_pk_fma_f32 v[70:71], v[70:71], s[38:39], v[50:51] neg_lo:[0,0,1] neg_hi:[0,0,1]
    v_exp_f32 v70, v70
    s_waitcnt vmcnt(9)
    v_mfma_f32_16x16x16_bf16 v[32:35], v[156:157], v[240:241], v[32:35]
    v_exp_f32 v71, v71
    v_cvt_pk_bf16_f32 v160, v68, v68
    v_mfma_f32_16x16x16_bf16 v[36:39], v[156:157], v[242:243], v[36:39]
    v_cvt_pk_bf16_f32 v162, v69, v69
    v_and_b32 v161, v160, v15
    v_xor_b32 v17, 0x4000, v8
    global_load_dwordx4 v[120:123], v17, s[14:15] nt
    s_waitcnt vmcnt(9)
    v_mfma_f32_16x16x16_bf16 v[32:35], v[158:159], v[244:245], v[32:35]
    v_and_b32 v160, v160, v14
    v_and_b32 v163, v162, v15
    v_mfma_f32_16x16x16_bf16 v[36:39], v[158:159], v[246:247], v[36:39]
    v_xor_b32 v16, 0x5000, v8
    global_load_dwordx4 v[124:127], v16, s[14:15] nt
    v_and_b32 v162, v162, v14
    v_pk_add_f32 v[40:41], v[40:41], v[68:69]
    s_nop 1
    s_waitcnt vmcnt(9)
    v_mfma_f32_16x16x16_bf16 v[32:35], v[160:161], v[248:249], v[32:35]
    v_cvt_pk_bf16_f32 v164, v70, v70
    v_cvt_pk_bf16_f32 v166, v71, v71
    v_mfma_f32_16x16x16_bf16 v[36:39], v[160:161], v[250:251], v[36:39]
    v_and_b32 v165, v164, v15
    v_and_b32 v164, v164, v14
    v_xor_b32 v17, 0x6000, v8
    global_load_dwordx4 v[128:131], v17, s[14:15] nt
    s_waitcnt vmcnt(9)
    v_mfma_f32_16x16x16_bf16 v[32:35], v[162:163], v[252:253], v[32:35]
    v_and_b32 v167, v166, v15
    v_and_b32 v166, v166, v14
    v_mfma_f32_16x16x16_bf16 v[36:39], v[162:163], v[254:255], v[36:39]
    v_xor_b32 v16, 0x7000, v8
    global_load_dwordx4 v[132:135], v16, s[14:15] nt
    v_pk_add_f32 v[40:41], v[40:41], v[70:71]
    v_add_f32 v40, v40, v41
    v_mov_b32 v41, v40
    s_nop 1
    v_permlane32_swap_b32 v40, v41
    v_add_f32 v40, v40, v41
    v_mov_b32 v41, v40
    s_nop 1
    v_permlane16_swap_b32 v40, v41
    v_add_f32 v40, v40, v41
    ds_write_b32 v52, v40 offset:3200
    s_waitcnt vmcnt(9)
    v_mfma_f32_16x16x16_bf16 v[32:35], v[164:165], v[72:73], v[32:35]
    v_mfma_f32_16x16x16_bf16 v[36:39], v[164:165], v[74:75], v[36:39]
    s_waitcnt vmcnt(8)
    v_mfma_f32_16x16x16_bf16 v[32:35], v[166:167], v[76:77], v[32:35]
    v_mfma_f32_16x16x16_bf16 v[36:39], v[166:167], v[78:79], v[36:39]
    s_nop 6
    ds_write_b128 v20, v[32:35] offset:4096
    ds_write_b128 v20, v[36:39] offset:5120
    s_mov_b64 exec, 1
    ds_add_u32 v18, v19 offset:3136
    s_mov_b32 exec_lo, -1
    s_mov_b32 exec_hi, 1
    s_mov_b32 s35, 60000
L_cnt:
    ds_read_b32 v5, v18 offset:3136
    ds_read_b128 v[40:43], v21 offset:4096
    ds_read_b128 v[44:47], v21 offset:6144
    ds_read_b128 v[48:51], v21 offset:8192
    ds_read_b128 v[52:55], v21 offset:10240
    ds_read_b128 v[68:71], v98 offset:3200
    s_sub_u32 s35, s35, 1
    s_cbranch_scc1 L_cntx
    s_waitcnt lgkmcnt(0)
    v_cmp_ne_u32 vcc, 4, v5
    s_cbranch_vccnz L_cnt
L_cntx:
    v_pk_add_f32 v[68:69], v[68:69], v[70:71]
    v_pk_add_f32 v[40:41], v[40:41], v[44:45]
    v_pk_add_f32 v[48:49], v[48:49], v[52:53]
    v_pk_add_f32 v[42:43], v[42:43], v[46:47]
    v_pk_add_f32 v[50:51], v[50:51], v[54:55]
    v_pk_add_f32 v[40:41], v[40:41], v[48:49]
    v_pk_add_f32 v[42:43], v[42:43], v[50:51]
    v_add_f32 v68, v68, v69
    v_cndmask_b32 v40, v40, v99, s[50:51]
    v_cndmask_b32 v41, v41, v68, s[50:51]
    v_and_or_b32 v42, v42, s33, v26
    v_and_or_b32 v43, v43, s33, v27
    v_and_or_b32 v40, v40, s33, v24
    v_and_or_b32 v41, v41, s33, v25
    s_cmp_lg_u32 s40, 0
    s_cbranch_scc1 L_wt_o
    global_store_dwordx4 v22, v[40:43], s[22:23]
    s_branch L_sd_o
L_wt_o:
    global_store_dwordx4 v22, v[40:43], s[22:23] sc1
L_sd_o:
    s_mov_b64 exec, -1
    s_waitcnt vmcnt(2)
    s_mov_b32 s35, 0
    s_mov_b64 s[44:45], -1
    s_mov_b64 s[46:47], -1
    s_mov_b64 s[48:49], -1
L_opoll:
    s_mov_b64 exec, s[48:49]
    s_cbranch_execz L_osk2
    global_load_dwordx4 v[144:147], v97, s[22:23] offset:0 sc1
L_osk2:
    s_mov_b64 exec, s[44:45]
    s_cbranch_execz L_osk0
    global_load_dwordx4 v[136:139], v23, s[22:23] offset:0 sc1
L_osk0:
    s_mov_b64 exec, s[46:47]
    s_cbranch_execz L_osk1
    global_load_dwordx4 v[140:143], v23, s[22:23] offset:1024 sc1
L_osk1:
    s_mov_b64 exec, -1
    s_add_u32 s35, s35, 1
    s_waitcnt vmcnt(0)
    v_xor_b32 v64, v144, v24
    v_xor_b32 v65, v145, v25
    v_xor_b32 v66, v146, v26
    v_xor_b32 v67, v147, v27
    v_xor_b32 v56, v136, v24
    v_xor_b32 v57, v137, v25
    v_xor_b32 v58, v138, v26
    v_xor_b32 v59, v139, v27
    v_xor_b32 v60, v140, v24
    v_xor_b32 v61, v141, v25
    v_xor_b32 v62, v142, v26
    v_xor_b32 v63, v143, v27
    v_max_f32_dpp v53, v64, v64 quad_perm:[1,0,3,2] row_mask:0xf bank_mask:0xf
    v_or3_b32 v48, v56, v57, v58
    v_or3_b32 v49, v60, v61, v62
    v_or3_b32 v50, v64, v65, v66
    v_max_f32_dpp v53, v53, v53 row_ror:8 row_mask:0xf bank_mask:0xf
    v_mov_b32 v54, v53
    v_bitop3_b32 v48, v48, v59, s33 bitop3:0x54
    v_bitop3_b32 v49, v49, v63, s33 bitop3:0x54
    v_bitop3_b32 v50, v50, v67, s33 bitop3:0x54
    v_permlane16_swap_b32 v53, v54
    v_max_f32 v53, v53, v54
    v_mov_b32 v54, v53
    v_cmp_ne_u32 s[44:45], 0, v48
    v_cmp_ne_u32 s[46:47], 0, v49
    v_cmp_ne_u32 s[48:49], 0, v50
    v_permlane32_swap_b32 v53, v54
    v_max_f32 v53, v53, v54
    s_or_b64 s[42:43], s[44:45], s[46:47]
    v_sub_f32 v52, v64, v53
    s_or_b64 s[42:43], s[42:43], s[48:49]
    v_mul_f32 v52, s38, v52
    s_cbranch_scc0 L_ogot
    s_cmp_lt_u32 s35, 60000
    s_cbranch_scc1 L_opoll
L_ogot:
    v_exp_f32 v52, v52
    s_nop 0
    v_mul_f32 v53, v52, v65
    v_mul_f32_dpp v56, v52, v56 quad_perm:[0,0,2,2] row_mask:0xf bank_mask:0xf
    v_mul_f32_dpp v57, v52, v57 quad_perm:[0,0,2,2] row_mask:0xf bank_mask:0xf
    v_mul_f32_dpp v58, v52, v58 quad_perm:[0,0,2,2] row_mask:0xf bank_mask:0xf
    v_add_f32_dpp v53, v53, v53 quad_perm:[1,0,3,2] row_mask:0xf bank_mask:0xf
    v_mul_f32_dpp v59, v52, v59 quad_perm:[0,0,2,2] row_mask:0xf bank_mask:0xf
    v_fmac_f32_dpp v56, v52, v60 quad_perm:[1,1,3,3] row_mask:0xf bank_mask:0xf
    v_fmac_f32_dpp v57, v52, v61 quad_perm:[1,1,3,3] row_mask:0xf bank_mask:0xf
    v_add_f32_dpp v53, v53, v53 row_ror:8 row_mask:0xf bank_mask:0xf
    v_fmac_f32_dpp v58, v52, v62 quad_perm:[1,1,3,3] row_mask:0xf bank_mask:0xf
    v_fmac_f32_dpp v59, v52, v63 quad_perm:[1,1,3,3] row_mask:0xf bank_mask:0xf
    v_mov_b32 v54, v53
    v_permlane32_swap_b32 v56, v57
    v_permlane32_swap_b32 v58, v59
    v_permlane32_swap_b32 v53, v54
    v_add_f32 v56, v56, v57
    v_add_f32 v58, v58, v59
    v_add_f32 v53, v53, v54
    v_mov_b32 v54, v53
    v_permlane16_swap_b32 v56, v58
    v_add_f32 v56, v56, v58
    v_permlane16_swap_b32 v53, v54
    v_add_f32 v53, v53, v54
    v_rcp_f32 v53, v53
    v_add_f32_dpp v56, v56, v56 row_ror:8 row_mask:0xf bank_mask:0xf
    v_mul_f32 v56, v56, v53
    v_cvt_pk_bf16_f32 v56, v56, v56
    s_nop 1
    v_and_b32_dpp v168, v56, v10 row_newbcast:0 row_mask:0xf bank_mask:0xf
    v_and_b32_dpp v169, v56, v11 row_newbcast:0 row_mask:0xf bank_mask:0xf
    v_and_b32_dpp v170, v56, v12 row_newbcast:0 row_mask:0xf bank_mask:0xf
    v_and_b32_dpp v171, v56, v13 row_newbcast:0 row_mask:0xf bank_mask:0xf
    v_and_b32_dpp v172, v56, v10 row_newbcast:1 row_mask:0xf bank_mask:0xf
    v_and_b32_dpp v173, v56, v11 row_newbcast:1 row_mask:0xf bank_mask:0xf
    v_and_b32_dpp v174, v56, v12 row_newbcast:1 row_mask:0xf bank_mask:0xf
    v_and_b32_dpp v175, v56, v13 row_newbcast:1 row_mask:0xf bank_mask:0xf
    v_mfma_f32_16x16x32_bf16 v[32:35], v[168:171], v[104:107], 0
    v_and_b32_dpp v176, v56, v10 row_newbcast:2 row_mask:0xf bank_mask:0xf
    v_and_b32_dpp v177, v56, v11 row_newbcast:2 row_mask:0xf bank_mask:0xf
    v_and_b32_dpp v178, v56, v12 row_newbcast:2 row_mask:0xf bank_mask:0xf
    v_and_b32_dpp v179, v56, v13 row_newbcast:2 row_mask:0xf bank_mask:0xf
    v_mfma_f32_16x16x32_bf16 v[32:35], v[172:175], v[108:111], v[32:35]
    v_and_b32_dpp v180, v56, v10 row_newbcast:3 row_mask:0xf bank_mask:0xf
    v_and_b32_dpp v181, v56, v11 row_newbcast:3 row_mask:0xf bank_mask:0xf
    v_and_b32_dpp v182, v56, v12 row_newbcast:3 row_mask:0xf bank_mask:0xf
    v_and_b32_dpp v183, v56, v13 row_newbcast:3 row_mask:0xf bank_mask:0xf
    v_mfma_f32_16x16x32_bf16 v[32:35], v[176:179], v[112:115], v[32:35]
    v_and_b32_dpp v184, v56, v10 row_newbcast:4 row_mask:0xf bank_mask:0xf
    v_and_b32_dpp v185, v56, v11 row_newbcast:4 row_mask:0xf bank_mask:0xf
    v_and_b32_dpp v186, v56, v12 row_newbcast:4 row_mask:0xf bank_mask:0xf
    v_and_b32_dpp v187, v56, v13 row_newbcast:4 row_mask:0xf bank_mask:0xf
    v_mfma_f32_16x16x32_bf16 v[32:35], v[180:183], v[116:119], v[32:35]
    v_and_b32_dpp v188, v56, v10 row_newbcast:5 row_mask:0xf bank_mask:0xf
    v_and_b32_dpp v189, v56, v11 row_newbcast:5 row_mask:0xf bank_mask:0xf
    v_and_b32_dpp v190, v56, v12 row_newbcast:5 row_mask:0xf bank_mask:0xf
    v_and_b32_dpp v191, v56, v13 row_newbcast:5 row_mask:0xf bank_mask:0xf
    v_mfma_f32_16x16x32_bf16 v[32:35], v[184:187], v[120:123], v[32:35]
    v_and_b32_dpp v192, v56, v10 row_newbcast:6 row_mask:0xf bank_mask:0xf
    v_and_b32_dpp v193, v56, v11 row_newbcast:6 row_mask:0xf bank_mask:0xf
    v_and_b32_dpp v194, v56, v12 row_newbcast:6 row_mask:0xf bank_mask:0xf
    v_and_b32_dpp v195, v56, v13 row_newbcast:6 row_mask:0xf bank_mask:0xf
    v_mfma_f32_16x16x32_bf16 v[32:35], v[188:191], v[124:127], v[32:35]
    v_and_b32_dpp v196, v56, v10 row_newbcast:7 row_mask:0xf bank_mask:0xf
    v_and_b32_dpp v197, v56, v11 row_newbcast:7 row_mask:0xf bank_mask:0xf
    v_and_b32_dpp v198, v56, v12 row_newbcast:7 row_mask:0xf bank_mask:0xf
    v_and_b32_dpp v199, v56, v13 row_newbcast:7 row_mask:0xf bank_mask:0xf
    v_mfma_f32_16x16x32_bf16 v[32:35], v[192:195], v[128:131], v[32:35]
    s_nop 0
    v_mfma_f32_16x16x32_bf16 v[32:35], v[196:199], v[132:135], v[32:35]
    s_mov_b32 exec_hi, 0
    s_nop 6
    ds_write_b128 v96, v[32:35] offset:0
    s_waitcnt lgkmcnt(0)
    s_barrier
    s_endpgm
L_comm:
    s_load_dwordx8 s[16:23], s[0:1], 80
    v_lshrrev_b32 v2, 6, v0
    v_and_b32 v1, 63, v0
    v_bfe_u32 v3, v0, 4, 2
    s_lshr_b32 s27, s27, 6
    s_bfe_u32 s25, s2, 0x10003
    s_lshr_b32 s26, s2, 4
    s_lshl1_add_u32 s28, s24, s25
    v_mov_b32 v12, 0
    ds_write_b32 v12, v12 offset:3136
    v_lshlrev_b32 v7, 4, v1
    v_and_b32 v9, 31, v1
    v_lshlrev_b32 v9, 4, v9
    s_lshl_b32 s29, s28, 13
    s_add_u32 s29, s29, 0x20000
    s_lshl_b32 s30, s26, 9
    s_add_u32 s30, s30, s29
    v_add_u32 v28, s30, v9
    s_waitcnt lgkmcnt(0)
    s_load_dword s32, s[22:23], 0x0
    s_mov_b32 exec_hi, 0
    global_load_dwordx4 v[72:75], v28, s[22:23] sc1
    s_mov_b64 exec, -1
    v_lshrrev_b32 v29, 2, v4
    v_lshlrev_b32 v29, 11, v29
    v_lshl_add_u32 v29, v3, 7, v29
    v_and_b32 v12, 3, v1
    v_lshl_add_u32 v29, v12, 5, v29
    v_add_u32 v29, s29, v29
    v_add_u32 v10, 0x40000, v28
    s_mov_b32 s38, 0x3fb8aa3b
    s_mov_b32 s34, 0xffff0000
    s_getreg_b32 s31, hwreg(HW_REG_XCC_ID, 0, 4)
    s_waitcnt lgkmcnt(0)
    s_add_u32 s32, s32, 0x9E3779B9
    s_bfe_u32 s29, s32, 0xa0000
    v_mov_b32 v64, s29
    s_bfe_u32 s29, s32, 0xa000a
    v_mov_b32 v65, s29
    s_bfe_u32 s29, s32, 0xa0014
    v_mov_b32 v66, s29
    s_bfe_u32 s29, s32, 0xa0016
    v_mov_b32 v67, s29
    s_mov_b32 s33, 0xfffffc00
    v_and_b32 v68, 0x3f0, v67
    v_or_b32 v68, s31, v68
    s_mov_b32 exec_hi, 0
    s_barrier
    ds_read_b128 v[32:35], v9 offset:0
    ds_read_b128 v[36:39], v9 offset:512
    ds_read_b128 v[40:43], v9 offset:1024
    ds_read_b128 v[44:47], v9 offset:1536
    s_waitcnt lgkmcnt(0)
    v_pk_add_f32 v[32:33], v[32:33], v[36:37]
    v_pk_add_f32 v[40:41], v[40:41], v[44:45]
    v_pk_add_f32 v[34:35], v[34:35], v[38:39]
    v_pk_add_f32 v[42:43], v[42:43], v[46:47]
    v_pk_add_f32 v[32:33], v[32:33], v[40:41]
    v_pk_add_f32 v[34:35], v[34:35], v[42:43]
    v_add_u32 v32, 0x200, v32
    v_add_u32 v33, 0x200, v33
    v_add_u32 v34, 0x200, v34
    v_add_u32 v35, 0x200, v35
    v_and_or_b32 v20, v32, s33, v64
    v_and_or_b32 v21, v33, s33, v65
    v_and_or_b32 v22, v34, s33, v66
    v_and_or_b32 v23, v35, s33, v68
    global_store_dwordx4 v28, v[20:23], s[22:23]
    s_mov_b64 exec, -1
    s_lshl_b32 s29, s28, 4
    s_add_u32 s29, s29, s26
    s_lshl_b32 s30, s29, 11
    s_add_u32 s30, s30, 0x80000
    v_add_u32 v71, s30, v7
    s_lshr_b32 s30, s29, 2
    s_lshl_b32 s30, s30, 8
    s_add_u32 s30, s30, 0x10000
    v_lshlrev_b32 v30, 4, v4
    v_add_u32 v30, s30, v30
    s_and_b32 s29, s26, 3
    s_lshl_b32 s29, s29, 6
    s_lshl_b32 s30, s25, 5
    s_add_u32 s29, s29, s30
    s_lshl_b32 s30, s24, 2
    s_add_u32 s29, s29, s30
    s_lshr_b32 s30, s26, 2
    s_add_u32 s29, s29, s30
    s_lshl_b32 s29, s29, 9
    s_add_u32 s29, s29, 0x40000
    v_add_u32 v31, s29, v9
    s_lshl_b32 s29, s24, 4
    s_bfe_u32 s30, s2, 0x40003
    s_add_u32 s29, s29, s30
    s_lshr_b32 s30, s29, 5
    s_lshl_b32 s30, s30, 15
    s_and_b32 s31, s29, 31
    s_lshl_b32 s31, s31, 4
    s_add_u32 s30, s30, s31
    s_add_u32 s30, s30, 0x40000
    v_lshlrev_b32 v70, 9, v1
    v_add_u32 v70, s30, v70
    v_and_b32 v69, 1, v3
    v_bfe_u32 v12, v1, 3, 1
    v_lshl_add_u32 v69, v12, 1, v69
    v_lshlrev_b32 v69, 1, v69
    s_lshl_b32 s29, s29, 3
    v_add_u32 v69, s29, v69
    s_mov_b32 s35, 0
L_pollq:
    global_load_dwordx4 v[32:35], v29, s[22:23] offset:0 sc1
    global_load_dwordx4 v[36:39], v29, s[22:23] offset:16 sc1
    global_load_dwordx4 v[40:43], v29, s[22:23] offset:512 sc1
    global_load_dwordx4 v[44:47], v29, s[22:23] offset:528 sc1
    global_load_dwordx4 v[48:51], v29, s[22:23] offset:1024 sc1
    global_load_dwordx4 v[52:55], v29, s[22:23] offset:1040 sc1
    global_load_dwordx4 v[56:59], v29, s[22:23] offset:1536 sc1
    global_load_dwordx4 v[60:63], v29, s[22:23] offset:1552 sc1
    s_add_u32 s35, s35, 1
    s_waitcnt vmcnt(0)
    v_xor_b32 v32, v32, v64
    v_xor_b32 v33, v33, v65
    v_xor_b32 v34, v34, v66
    v_xor_b32 v35, v35, v68
    v_xor_b32 v36, v36, v64
    v_xor_b32 v37, v37, v65
    v_xor_b32 v38, v38, v66
    v_xor_b32 v39, v39, v68
    v_xor_b32 v40, v40, v64
    v_xor_b32 v41, v41, v65
    v_xor_b32 v42, v42, v66
    v_xor_b32 v43, v43, v68
    v_xor_b32 v44, v44, v64
    v_xor_b32 v45, v45, v65
    v_xor_b32 v46, v46, v66
    v_xor_b32 v47, v47, v68
    v_xor_b32 v48, v48, v64
    v_xor_b32 v49, v49, v65
    v_xor_b32 v50, v50, v66
    v_xor_b32 v51, v51, v68
    v_xor_b32 v52, v52, v64
    v_xor_b32 v53, v53, v65
    v_xor_b32 v54, v54, v66
    v_xor_b32 v55, v55, v68
    v_xor_b32 v56, v56, v64
    v_xor_b32 v57, v57, v65
    v_xor_b32 v58, v58, v66
    v_xor_b32 v59, v59, v68
    v_xor_b32 v60, v60, v64
    v_xor_b32 v61, v61, v65
    v_xor_b32 v62, v62, v66
    v_xor_b32 v63, v63, v68
    v_or3_b32 v13, v35, v39, v43
    v_or3_b32 v13, v13, v47, v51
    v_or3_b32 v13, v13, v55, v59
    v_or_b32 v13, v13, v63
    v_and_b32 v12, -16, v13
    v_or3_b32 v12, v12, v32, v33
    v_or3_b32 v12, v12, v34, v36
    v_or3_b32 v12, v12, v37, v38
    v_or3_b32 v12, v12, v40, v41
    v_or3_b32 v12, v12, v42, v44
    v_or3_b32 v12, v12, v45, v46
    v_or3_b32 v12, v12, v48, v49
    v_or3_b32 v12, v12, v50, v52
    v_or3_b32 v12, v12, v53, v54
    v_or3_b32 v12, v12, v56, v57
    v_or3_b32 v12, v12, v58, v60
    v_or3_b32 v12, v12, v61, v62
    v_and_b32 v12, 0x3ff, v12
    v_cmp_ne_u32 vcc, 0, v12
    s_cbranch_vccz L_gotq
    s_cmp_lt_u32 s35, 12
    s_cbranch_scc1 L_pollq
    v_xor_b32 v29, 0x40000, v29
    s_cmp_lg_u32 s35, 12
    s_cbranch_scc1 L_nswq
    s_mov_b32 exec_hi, 0
    global_store_dwordx4 v10, v[20:23], s[22:23] sc1
    s_mov_b64 exec, -1
L_nswq:
    s_cmp_lt_u32 s35, 60000
    s_cbranch_scc1 L_pollq
L_gotq:
    v_and_b32 v13, 15, v13
    v_cmp_ne_u32 vcc, 0, v13
    v_and_b32 v35, -16, v35
    v_and_b32 v39, -16, v39
    v_and_b32 v43, -16, v43
    v_and_b32 v47, -16, v47
    v_and_b32 v51, -16, v51
    v_and_b32 v55, -16, v55
    v_and_b32 v59, -16, v59
    v_and_b32 v63, -16, v63
    s_or_b32 s40, vcc_lo, vcc_hi
    s_cmp_eq_u32 s40, 0
    s_cbranch_scc1 L_qloc
    s_mov_b32 exec_hi, 0
    global_store_dwordx4 v10, v[20:23], s[22:23] sc1
    s_mov_b64 exec, -1
L_qloc:
    v_pk_add_f32 v[32:33], v[32:33], v[40:41]
    v_pk_add_f32 v[48:49], v[48:49], v[56:57]
    v_pk_add_f32 v[34:35], v[34:35], v[42:43]
    v_pk_add_f32 v[50:51], v[50:51], v[58:59]
    v_pk_add_f32 v[36:37], v[36:37], v[44:45]
    v_pk_add_f32 v[52:53], v[52:53], v[60:61]
    v_pk_add_f32 v[38:39], v[38:39], v[46:47]
    v_pk_add_f32 v[54:55], v[54:55], v[62:63]
    v_pk_add_f32 v[32:33], v[32:33], v[48:49]
    v_pk_add_f32 v[34:35], v[34:35], v[50:51]
    v_pk_add_f32 v[36:37], v[36:37], v[52:53]
    v_pk_add_f32 v[38:39], v[38:39], v[54:55]
    v_cvt_pk_bf16_f32 v12, v32, v33
    v_cvt_pk_bf16_f32 v13, v34, v35
    v_cvt_pk_bf16_f32 v14, v36, v37
    v_cvt_pk_bf16_f32 v15, v38, v39
    v_mov_b32 v16, s40
    v_mov_b32 v17, s32
    v_mov_b32 v18, 0
    ds_write_b128 v7, v[12:15] offset:2048
    ds_write_b64 v18, v[16:17] offset:3144
    global_load_dwordx4 v[32:35], v7, s[4:5]
    global_load_dwordx4 v[36:39], v7, s[16:17]
    global_load_dwordx4 v[72:75], v71, s[22:23] sc1
    global_load_dwordx4 v[76:79], v71, s[22:23] offset:1024 sc1
    global_load_dwordx4 v[80:83], v30, s[22:23] sc1
    s_cmp_ge_u32 s2, 128
    s_cbranch_scc1 L_nofp
    global_load_dwordx4 v[84:87], v70, s[22:23] sc1
L_nofp:
    s_waitcnt lgkmcnt(0)
    s_barrier
    s_barrier
    s_waitcnt vmcnt(0)
    v_lshlrev_b32 v12, 16, v32
    v_and_b32 v13, s34, v32
    v_lshlrev_b32 v20, 16, v36
    v_and_b32 v21, s34, v36
    v_lshlrev_b32 v14, 16, v33
    v_and_b32 v15, s34, v33
    v_lshlrev_b32 v22, 16, v37
    v_and_b32 v23, s34, v37
    v_lshlrev_b32 v16, 16, v34
    v_and_b32 v17, s34, v34
    v_lshlrev_b32 v24, 16, v38
    v_and_b32 v25, s34, v38
    v_lshlrev_b32 v18, 16, v35
    v_and_b32 v19, s34, v35
    v_lshlrev_b32 v26, 16, v39
    v_and_b32 v27, s34, v39
    v_mul_f32 v12, v12, v20
    v_mul_f32 v13, v13, v21
    v_mul_f32 v14, v14, v22
    v_mul_f32 v15, v15, v23
    v_mul_f32 v16, v16, v24
    v_mul_f32 v17, v17, v25
    v_mul_f32 v18, v18, v26
    v_mul_f32 v19, v19, v27
    v_cvt_pk_bf16_f32 v20, v12, v13
    v_cvt_pk_bf16_f32 v21, v14, v15
    v_cvt_pk_bf16_f32 v22, v16, v17
    v_cvt_pk_bf16_f32 v23, v18, v19
    v_lshlrev_b32 v12, 16, v20
    v_and_b32 v13, s34, v20
    v_lshlrev_b32 v14, 16, v21
    v_and_b32 v15, s34, v21
    v_lshlrev_b32 v16, 16, v22
    v_and_b32 v17, s34, v22
    v_lshlrev_b32 v18, 16, v23
    v_and_b32 v19, s34, v23
    v_add_f32 v12, v12, v16
    v_add_f32 v13, v13, v17
    v_add_f32 v14, v14, v18
    v_add_f32 v15, v15, v19
    v_add_f32 v12, v12, v14
    v_add_f32 v13, v13, v15
    v_add_f32 v12, v12, v13
    s_nop 1
    v_add_f32_dpp v12, v12, v12 row_ror:8 row_mask:0xf bank_mask:0xf
    s_nop 1
    v_add_f32_dpp v12, v12, v12 row_ror:4 row_mask:0xf bank_mask:0xf
    s_nop 1
    v_add_f32_dpp v12, v12, v12 row_ror:2 row_mask:0xf bank_mask:0xf
    s_nop 1
    v_add_f32_dpp v12, v12, v12 row_ror:1 row_mask:0xf bank_mask:0xf
    v_mov_b32 v13, v12
    s_nop 1
    v_permlane32_swap_b32 v12, v13
    v_add_f32 v12, v12, v13
    v_mov_b32 v13, v12
    s_nop 1
    v_permlane16_swap_b32 v12, v13
    v_add_f32 v12, v12, v13
    v_cvt_pk_bf16_f32 v12, v12, v12
    v_and_b32 v12, s34, v12
    v_mul_f32 v12, s38, v12
    v_exp_f32 v12, -v12
    s_nop 0
    v_add_f32 v12, 1.0, v12
    v_rcp_f32 v12, v12
    s_nop 0
    v_cvt_pk_bf16_f32 v12, v12, v12
    v_and_b32 v13, s34, v12
    v_sub_f32 v12, 1.0, v13
    v_cmp_gt_u32 vcc, 32, v1
    v_cvt_pk_bf16_f32 v12, v12, v12
    v_and_b32 v12, s34, v12
    v_cndmask_b32 v11, v12, v13, vcc
    s_mov_b32 s50, 0xff00ff00
    s_mov_b32 s51, 0xff00ff00
    s_mov_b32 exec_hi, 0
    s_barrier
    ds_read_b128 v[32:35], v9 offset:0
    ds_read_b128 v[36:39], v9 offset:512
    ds_read_b128 v[40:43], v9 offset:1024
    ds_read_b128 v[44:47], v9 offset:1536
    s_waitcnt lgkmcnt(0)
    v_pk_add_f32 v[32:33], v[32:33], v[36:37]
    v_pk_add_f32 v[40:41], v[40:41], v[44:45]
    v_pk_add_f32 v[34:35], v[34:35], v[38:39]
    v_pk_add_f32 v[42:43], v[42:43], v[46:47]
    v_pk_add_f32 v[32:33], v[32:33], v[40:41]
    v_pk_add_f32 v[34:35], v[34:35], v[42:43]
    v_and_or_b32 v20, v32, s33, v64
    v_and_or_b32 v21, v33, s33, v65
    v_and_or_b32 v22, v34, s33, v66
    v_and_or_b32 v23, v35, s33, v67
    global_store_dwordx4 v31, v[20:23], s[22:23] sc1
    s_mov_b64 exec, -1
    s_cmp_ge_u32 s2, 128
    s_cbranch_scc1 L_fin
    s_waitcnt vmcnt(0)
    s_mov_b32 s35, 0
    s_mov_b64 vcc, -1
L_pollf:
    s_mov_b64 exec, vcc
    global_load_dwordx4 v[84:87], v70, s[22:23] sc1
    s_mov_b64 exec, -1
    s_add_u32 s35, s35, 1
    s_waitcnt vmcnt(0)
    v_xor_b32 v32, v84, v64
    v_xor_b32 v33, v85, v65
    v_xor_b32 v34, v86, v66
    v_xor_b32 v35, v87, v67
    v_or3_b32 v12, v32, v33, v34
    v_bitop3_b32 v12, v12, v35, s33 bitop3:0x54
    v_cmp_ne_u32 vcc, 0, v12
    s_cbranch_vccz L_gotf
    s_cmp_lt_u32 s35, 60000
    s_cbranch_scc1 L_pollf
L_gotf:
    v_permlane16_swap_b32 v32, v33
    v_permlane16_swap_b32 v34, v35
    v_add_f32 v32, v32, v33
    v_add_f32 v34, v34, v35
    s_nop 0
    v_add_f32_dpp v33, v32, v32 row_ror:8 row_mask:0xf bank_mask:0xf
    v_add_f32_dpp v35, v34, v34 row_ror:8 row_mask:0xf bank_mask:0xf
    v_cndmask_b32 v12, v33, v35, s[50:51]
    s_nop 1
    v_add_f32_dpp v12, v12, v12 quad_perm:[1,0,3,2] row_mask:0xf bank_mask:0xf
    s_nop 1
    v_add_f32_dpp v12, v12, v12 quad_perm:[2,3,0,1] row_mask:0xf bank_mask:0xf
    s_nop 1
    v_add_f32_dpp v12, v12, v12 row_half_mirror row_mask:0xf bank_mask:0xf
    v_cvt_pk_bf16_f32 v12, v12, v12
    v_and_b32 v12, s34, v12
    v_mul_f32 v12, v12, v11
    v_cvt_pk_bf16_f32 v12, v12, v12
    v_and_b32 v12, s34, v12
    v_mov_b32 v13, v12
    s_nop 1
    v_permlane32_swap_b32 v12, v13
    v_add_f32 v12, v12, v13
    v_cvt_pk_bf16_f32 v12, v12, v12
    s_mov_b64 exec, 0x01010101
    global_store_short v69, v12, s[18:19]
    s_cmp_lg_u32 s2, 0
    s_cbranch_scc1 L_fin
    s_mov_b64 exec, 1
    v_mov_b32 v14, s32
    v_mov_b32 v15, 0
    global_store_dword v15, v14, s[22:23] offset:0
L_fin:
L_end:
    s_endpgm
.section .rodata,"a"
.p2align 6
.amdhsa_kernel gated_mix__sliding_block_cached__sliding_block_cached__decode_kernel
  .amdhsa_next_free_vgpr 256
  .amdhsa_next_free_sgpr 102
  .amdhsa_accum_offset 256
  .amdhsa_group_segment_fixed_size 0
  .amdhsa_kernarg_size 112
  .amdhsa_user_sgpr_count 2
  .amdhsa_user_sgpr_kernarg_segment_ptr 1
  .amdhsa_system_sgpr_workgroup_id_x 1
.end_amdhsa_kernel
```
